```python
import torch

def _softmax(x, axis=-1):
    return torch.softmax(x, dim=axis)
def _gelu(x):
    return torch.nn.functional.gelu(x, approximate="tanh")
def _silu(x):
    return torch.nn.functional.silu(x)
def _sigmoid(x):
    return torch.sigmoid(x)
def _layernorm(x, axis=-1, eps=1e-5):
    m = x.mean(dim=axis, keepdim=True)
    v = x.var(dim=axis, keepdim=True, unbiased=False)
    return (x - m) / torch.sqrt(v + eps)
def _scatter_add(tgt, idx, src, axis=0):
    return tgt.clone().index_add_(axis, idx, src)
def _segment_sum(src, seg, n):
    out = torch.zeros((n,) + src.shape[1:], dtype=src.dtype)
    return out.index_add_(0, seg, src)
def _pad(x, pw):
    flat = tuple(v for pair in reversed(pw) for v in pair)
    return torch.nn.functional.pad(x, flat)

kernel_name = 'parallel_sum__sliding_block_cached__swiglu_ffn__decode'

def setup_inputs():

    _w = (lambda a: (lambda t: t.to(torch.bfloat16) if t.is_floating_point() else t)(torch.as_tensor(a)))
    def _A_setup():
        B, Sq, D = 4, 1, 512
        Hq, Hkv, Sk, Dh = 32, 8, 16384, 128
        assert Hq % Hkv == 0, (Hq, Hkv)
        return {
            "x": _w((lambda *s: torch.randn(*s, dtype=torch.bfloat16) * 0.05)(B, Sq, D)),
            "k_cache": _w((lambda *s: torch.randn(*s, dtype=torch.bfloat16) * 3.2)(B, Hkv, Sk, Dh)),
            "v_cache": _w((lambda *s: torch.randn(*s, dtype=torch.bfloat16) * 1.6)(B, Hkv, Sk, Dh)),
            "wq": _w((lambda *s: torch.randn(*s, dtype=torch.bfloat16) * 3.2)(D, Hq * Dh) * (D ** -0.5)),
            "wo": _w((lambda *s: torch.randn(*s, dtype=torch.bfloat16) * 1.6)(Hq * Dh, D) * ((Hq * Dh) ** -0.5)),
        }
    _A_in = _A_setup()

    def _B_setup():
        B, S, D, F = 4, 1, 512, 1792
        return {
            "x": _w((lambda *s: torch.randn(*s, dtype=torch.bfloat16) * 0.05)(B, S, D)),
            "w_gate": _w((lambda *s: torch.randn(*s, dtype=torch.bfloat16) * 0.05)(D, F)),
            "w_up": _w((lambda *s: torch.randn(*s, dtype=torch.bfloat16) * 0.05)(D, F)),
            "w_down": _w((lambda *s: torch.randn(*s, dtype=torch.bfloat16) * 0.05)(F, D)),
        }
    _B_in = _B_setup()

    return {
        "A_x": _A_in["x"],
        "A_k_cache": _A_in["k_cache"],
        "A_v_cache": _A_in["v_cache"],
        "A_wq": _A_in["wq"],
        "A_wo": _A_in["wo"],
        "B_x": _B_in["x"],
        "B_w_gate": _B_in["w_gate"],
        "B_w_up": _B_in["w_up"],
        "B_w_down": _B_in["w_down"],
    }

def reference(A_x, A_k_cache, A_v_cache, A_wq, A_wo, B_x, B_w_gate, B_w_up, B_w_down):
    def _A_ref(x, k_cache, v_cache, wq, wo):
        B, Sq, D = x.shape
        Hq, Dh = 32, 128
        Hkv, Sk = k_cache.shape[1], k_cache.shape[2]
        W = min(4096, max(256, Sk // 4))
        rep = Hq // Hkv
        q = (lambda x, *d: x.permute(*d))((x @ wq).reshape(B, Sq, Hq, Dh), 0, 2, 1, 3)
        k = (lambda x, n, axis: torch.repeat_interleave(x, n, dim=axis))(k_cache[:, :, Sk - W:, :], rep, axis=1)
        v = (lambda x, n, axis: torch.repeat_interleave(x, n, dim=axis))(v_cache[:, :, Sk - W:, :], rep, axis=1)
        scores = torch.einsum("bhqd,bhkd->bhqk", q, k) * (Dh ** -0.5)
        p = _softmax(scores, axis=-1)
        o = torch.einsum("bhqk,bhkd->bhqd", p, v)
        return (lambda x, *d: x.permute(*d))(o, 0, 2, 1, 3).reshape(B, Sq, Hq * Dh) @ wo

    def _B_ref(x, w_gate, w_up, w_down):
        g = _silu(x @ w_gate)
        u = x @ w_up
        return (g * u) @ w_down

    x = A_x
    xn = _layernorm(x, axis=-1)
    return x + _A_ref(xn, A_k_cache, A_v_cache, A_wq, A_wo) + _B_ref(xn, B_w_gate, B_w_up, B_w_down)
```

```asm
; @launch grid=(256,1,1) block=(512,1,1) lds=150336
.amdgcn_target "amdgcn-amd-amdhsa--gfx950"
.text
.globl parallel_sum__sliding_block_cached__swiglu_ffn__decode_kernel
.p2align 12
.p2align 8
.type parallel_sum__sliding_block_cached__swiglu_ffn__decode_kernel,@function
parallel_sum__sliding_block_cached__swiglu_ffn__decode_kernel:
    s_load_dwordx16 s[4:19], s[0:1], 0
    s_load_dwordx8 s[20:27], s[0:1], 64
    v_lshrrev_b32 v1, 6, v0
    v_and_b32 v0, 63, v0
    s_and_b32 s29, s2, 7
    v_readfirstlane_b32 s28, v1
    s_lshr_b32 s30, s2, 3
    s_cmp_ge_u32 s2, 256
    s_cbranch_scc1 L_end
    v_lshrrev_b32 v2, 4, v0
    v_and_b32 v3, 15, v0
    s_and_b32 s49, s30, 24
    s_add_u32 s49, s49, s29
    s_cmp_lt_u32 s28, 4
    s_cbranch_scc1 L_front
    s_sub_u32 s50, s28, 4
    s_lshl_b32 s51, s49, 5
    s_and_b32 s54, s30, 7
    s_add_u32 s51, s51, s54
    s_add_u32 s51, s51, 24
    s_lshl_b32 s51, s51, 17
    s_add_u32 s52, s30, s50
    s_lshl_b32 s52, s52, 12
    s_lshl_b32 s53, s50, 15
    v_lshlrev_b32 v4, 2, v2
    v_xor_b32 v4, v4, v3
    v_lshlrev_b32 v5, 4, v2
    v_or_b32 v4, v4, v5
    v_lshlrev_b32 v16, 4, v4
    v_xor_b32 v17, 16, v16
    v_xor_b32 v18, 32, v16
    v_xor_b32 v19, 48, v16
    s_mov_b32 s55, s52
    s_mov_b32 m0, s53
    s_add_u32 s53, s53, 32768
    s_brev_b32 s38, 16
    s_mov_b32 s39, 0x20000
    s_waitcnt lgkmcnt(0)
    s_mov_b32 s36, s6
    s_and_b32 s37, s7, 0xffff
    s_barrier
    s_load_dword s14, s[26:27], 0
L_kloop:
    s_and_b32 s54, s55, 0x1ffff
    s_add_u32 s54, s54, s51
    s_waitcnt vmcnt(5)
    buffer_load_dwordx4 v16, s[36:39], s54 offen offset:0 nt lds
    s_waitcnt vmcnt(5)
    buffer_load_dwordx4 v17, s[36:39], s54 offen offset:1024 nt lds
    s_waitcnt vmcnt(5)
    buffer_load_dwordx4 v18, s[36:39], s54 offen offset:2048 nt lds
    s_waitcnt vmcnt(5)
    buffer_load_dwordx4 v19, s[36:39], s54 offen offset:3072 nt lds
    s_add_u32 s55, s55, 16384
    s_add_u32 m0, m0, 4096
    s_cmp_lt_u32 m0, s53
    s_cbranch_scc1 L_kloop
    s_branch L_att
L_front:
    s_lshr_b32 s49, s29, 1
    s_mul_i32 s49, s49, 7
    s_lshr_b32 s55, s30, 3
    s_add_u32 s56, s55, 3
    s_max_u32 s56, s56, 4
    s_cmp_eq_u32 s55, 1
    s_cselect_b32 s56, -64, s56
    s_bitcmp1_b32 s29, 0
    s_cselect_b32 s55, s56, s55
    s_add_u32 s49, s49, s55
    v_lshlrev_b32 v5, 2, v0
    v_add_u32 v5, 132352, v5
    v_mov_b32 v6, 0
    ds_write_b32 v5, v6
    ds_write_b32 v5, v6 offset:128
    v_lshlrev_b32 v241, 4, v0
    v_lshrrev_b32 v242, 3, v3
    v_lshl_add_u32 v242, v242, 2, v2
    v_and_b32 v7, 7, v3
    s_and_b32 s54, s30, 1
    s_lshl2_add_u32 s54, s54, s28
    s_lshr_b32 s55, s30, 3
    s_bfe_u32 s56, s30, 0x10001
    s_xor_b32 s56, s56, 1
    s_lshl1_add_u32 s55, s55, s56
    s_lshl3_add_u32 s55, s29, s55
    s_max_i32 s57, s49, 0
    s_cmp_lt_i32 s49, 0
    s_cselect_b32 s52, 0, 1835008
    s_bitcmp1_b32 s30, 2
    s_cselect_b32 s55, s57, s55
    s_cselect_b32 s38, s52, 0x400000
    s_movk_i32 s56, 3584
    s_cselect_b32 s50, s56, 0x2000
    s_lshl_b32 s56, s54, 6
    s_mul_i32 s51, s56, s50
    s_lshl_b32 s56, s55, 7
    s_add_u32 s51, s51, s56
    s_lshl_b32 s56, s50, 3
    v_mul_lo_u32 v242, v242, s56
    v_lshl_add_u32 v242, v7, 4, v242
    s_mov_b32 s39, 0x20000
    s_movk_i32 s42, 4096
    s_mov_b32 s43, 0x20000
    s_lshl_b32 s55, s28, 10
    s_waitcnt lgkmcnt(0)
    s_mov_b32 s40, s4
    s_and_b32 s41, s5, 0xffff
    s_bitcmp1_b32 s30, 1
    s_cselect_b64 s[36:37], s[18:19], s[16:17]
    s_bitcmp1_b32 s30, 2
    s_cselect_b64 s[36:37], s[36:37], s[10:11]
    s_and_b32 s37, s37, 0xffff
    buffer_load_dwordx4 v[40:43], v242, s[36:39], s51 offen nt
    s_add_u32 s51, s51, s50
    buffer_load_dwordx4 v[44:47], v242, s[36:39], s51 offen nt
    s_add_u32 s51, s51, s50
    buffer_load_dwordx4 v[48:51], v242, s[36:39], s51 offen nt
    s_add_u32 s51, s51, s50
    buffer_load_dwordx4 v[52:55], v242, s[36:39], s51 offen nt
    s_add_u32 s51, s51, s50
    buffer_load_dwordx4 v[8:11], v241, s[40:43], s55 offen
    buffer_load_dwordx4 v[56:59], v242, s[36:39], s51 offen nt
    s_add_u32 s51, s51, s50
    buffer_load_dwordx4 v[60:63], v242, s[36:39], s51 offen nt
    s_add_u32 s51, s51, s50
    buffer_load_dwordx4 v[64:67], v242, s[36:39], s51 offen nt
    s_add_u32 s51, s51, s50
    buffer_load_dwordx4 v[68:71], v242, s[36:39], s51 offen nt
    s_load_dword s14, s[26:27], 0
    s_barrier
    s_getpc_b64 s[56:57]
L_pc:
    s_sub_u32 s56, s56, L_pc-parallel_sum__sliding_block_cached__swiglu_ffn__decode_kernel
    s_subb_u32 s57, s57, 0
    s_lshl2_add_u32 s52, s30, s28
    s_lshl_b32 s52, s52, 7
    v_and_b32 v7, 1, v0
    v_lshl_add_u32 v7, v7, 6, s52
    v_min_u32 v7, L_codeend-parallel_sum__sliding_block_cached__swiglu_ffn__decode_kernel-4, v7
    global_load_dword v254, v7, s[56:57]
    s_mov_b32 s44, 0x05040100
    s_mov_b32 s45, 0x07060302
    s_mov_b32 s32, s26
    s_and_b32 s33, s27, 0xffff
    s_mov_b32 s34, 2084864
    s_mov_b32 s35, 0x20000
    s_and_b32 s48, s30, 7
    s_lshl_b32 s65, s29, 12
    s_add_u32 s65, s65, 987136
    s_and_b32 s51, s30, 1
    s_lshl_b32 s3, s51, 17
    s_lshr_b32 s51, s30, 3
    s_bfe_u32 s52, s30, 0x10001
    s_xor_b32 s52, s52, 1
    s_lshl1_add_u32 s51, s51, s52
    s_lshl3_add_u32 s51, s29, s51
    s_lshl_b32 s51, s51, 9
    s_add_u32 s3, s3, s51
    s_add_u32 s3, s3, 4096
    s_and_b32 s51, s30, 3
    s_mul_i32 s24, s51, 57344
    s_max_i32 s51, s49, 0
    s_lshl_b32 s51, s51, 9
    s_add_u32 s24, s24, s51
    s_add_u32 s24, s24, 528384
    v_and_b32 v4, 31, v0
    v_lshlrev_b32 v4, 2, v4
    v_add_u32 v4, 132608, v4
    s_waitcnt vmcnt(5)
    v_lshlrev_b32 v72, 16, v8
    v_and_b32 v73, 0xffff0000, v8
    v_lshlrev_b32 v74, 16, v9
    v_and_b32 v75, 0xffff0000, v9
    v_lshlrev_b32 v76, 16, v10
    v_and_b32 v77, 0xffff0000, v10
    v_lshlrev_b32 v78, 16, v11
    v_and_b32 v79, 0xffff0000, v11
    v_pk_add_f32 v[12:13], v[72:73], v[74:75]
    v_pk_add_f32 v[14:15], v[76:77], v[78:79]
    v_pk_add_f32 v[12:13], v[12:13], v[14:15]
    v_add_f32 v16, v12, v13
    s_nop 1
    v_add_f32_dpp v16, v16, v16 quad_perm:[1,0,3,2] row_mask:0xf bank_mask:0xf
    s_nop 1
    v_add_f32_dpp v16, v16, v16 quad_perm:[2,3,0,1] row_mask:0xf bank_mask:0xf
    s_nop 1
    v_add_f32_dpp v16, v16, v16 row_ror:4 row_mask:0xf bank_mask:0xf
    s_nop 1
    v_add_f32_dpp v16, v16, v16 row_ror:8 row_mask:0xf bank_mask:0xf
    v_mov_b32 v18, v16
    s_nop 1
    v_permlane16_swap_b32 v16, v18
    s_nop 0
    v_add_f32 v16, v16, v18
    v_mov_b32 v18, v16
    s_nop 1
    v_permlane32_swap_b32 v16, v18
    s_nop 0
    v_add_f32 v16, v16, v18
    v_mul_f32 v16, 0x3b000000, v16
    v_mov_b32 v17, v16
    v_pk_add_f32 v[80:81], v[72:73], v[16:17] neg_lo:[0,1] neg_hi:[0,1]
    v_pk_add_f32 v[82:83], v[74:75], v[16:17] neg_lo:[0,1] neg_hi:[0,1]
    v_pk_add_f32 v[84:85], v[76:77], v[16:17] neg_lo:[0,1] neg_hi:[0,1]
    v_pk_add_f32 v[86:87], v[78:79], v[16:17] neg_lo:[0,1] neg_hi:[0,1]
    v_pk_mul_f32 v[12:13], v[80:81], v[80:81]
    v_pk_mul_f32 v[14:15], v[82:83], v[82:83]
    v_pk_fma_f32 v[12:13], v[84:85], v[84:85], v[12:13]
    v_pk_fma_f32 v[14:15], v[86:87], v[86:87], v[14:15]
    v_pk_add_f32 v[12:13], v[12:13], v[14:15]
    v_add_f32 v19, v12, v13
    s_nop 1
    v_add_f32_dpp v19, v19, v19 quad_perm:[1,0,3,2] row_mask:0xf bank_mask:0xf
    s_nop 1
    v_add_f32_dpp v19, v19, v19 quad_perm:[2,3,0,1] row_mask:0xf bank_mask:0xf
    s_nop 1
    v_add_f32_dpp v19, v19, v19 row_ror:4 row_mask:0xf bank_mask:0xf
    s_nop 1
    v_add_f32_dpp v19, v19, v19 row_ror:8 row_mask:0xf bank_mask:0xf
    v_mov_b32 v18, v19
    s_nop 1
    v_permlane16_swap_b32 v19, v18
    s_nop 0
    v_add_f32 v19, v19, v18
    v_mov_b32 v18, v19
    s_nop 1
    v_permlane32_swap_b32 v19, v18
    s_nop 0
    v_add_f32 v19, v19, v18
    v_mul_f32 v19, 0x3b000000, v19
    v_cvt_pk_bf16_f32 v16, v16, v16
    v_and_b32 v16, 0xffff0000, v16
    v_mov_b32 v17, v16
    v_cvt_pk_bf16_f32 v19, v19, v19
    v_and_b32 v19, 0xffff0000, v19
    v_add_f32 v19, 0x3727c5ac, v19
    v_cvt_pk_bf16_f32 v19, v19, v19
    v_and_b32 v19, 0xffff0000, v19
    v_sqrt_f32 v19, v19
    s_nop 0
    v_cvt_pk_bf16_f32 v19, v19, v19
    v_and_b32 v19, 0xffff0000, v19
    v_rcp_f32 v20, v19
    s_nop 0
    v_fma_f32 v18, -v19, v20, 1.0
    v_fma_f32 v20, v18, v20, v20
    v_mov_b32 v21, v20
    v_pk_add_f32 v[72:73], v[72:73], v[16:17] neg_lo:[0,1] neg_hi:[0,1]
    v_pk_add_f32 v[74:75], v[74:75], v[16:17] neg_lo:[0,1] neg_hi:[0,1]
    v_pk_add_f32 v[76:77], v[76:77], v[16:17] neg_lo:[0,1] neg_hi:[0,1]
    v_pk_add_f32 v[78:79], v[78:79], v[16:17] neg_lo:[0,1] neg_hi:[0,1]
    v_cvt_pk_bf16_f32 v8, v72, v73
    v_cvt_pk_bf16_f32 v9, v74, v75
    v_cvt_pk_bf16_f32 v10, v76, v77
    v_cvt_pk_bf16_f32 v11, v78, v79
    v_lshlrev_b32 v72, 16, v8
    v_and_b32 v73, 0xffff0000, v8
    v_lshlrev_b32 v74, 16, v9
    v_and_b32 v75, 0xffff0000, v9
    v_lshlrev_b32 v76, 16, v10
    v_and_b32 v77, 0xffff0000, v10
    v_lshlrev_b32 v78, 16, v11
    v_and_b32 v79, 0xffff0000, v11
    v_pk_mul_f32 v[80:81], v[72:73], v[20:21]
    v_pk_mul_f32 v[82:83], v[74:75], v[20:21]
    v_pk_mul_f32 v[84:85], v[76:77], v[20:21]
    v_pk_mul_f32 v[86:87], v[78:79], v[20:21]
    v_fma_f32 v72, -v80, v19, v72
    v_fma_f32 v73, -v81, v19, v73
    v_fma_f32 v74, -v82, v19, v74
    v_fma_f32 v75, -v83, v19, v75
    v_fma_f32 v76, -v84, v19, v76
    v_fma_f32 v77, -v85, v19, v77
    v_fma_f32 v78, -v86, v19, v78
    v_fma_f32 v79, -v87, v19, v79
    v_pk_fma_f32 v[80:81], v[72:73], v[20:21], v[80:81]
    v_pk_fma_f32 v[82:83], v[74:75], v[20:21], v[82:83]
    v_pk_fma_f32 v[84:85], v[76:77], v[20:21], v[84:85]
    v_pk_fma_f32 v[86:87], v[78:79], v[20:21], v[86:87]
    v_cvt_pk_bf16_f32 v8, v80, v81
    v_cvt_pk_bf16_f32 v9, v82, v83
    v_cvt_pk_bf16_f32 v10, v84, v85
    v_cvt_pk_bf16_f32 v11, v86, v87
    s_mul_i32 s55, s28, 1056
    s_add_u32 s55, s55, 138048
    v_add_u32 v5, s55, v241
    ds_write_b128 v5, v[8:11]
    s_lshl_b32 s55, s28, 2
    s_add_u32 s55, s55, 132608
    v_mov_b32 v252, s55
    v_mov_b32 v253, 1
    v_lshrrev_b32 v6, 2, v3
    v_mul_u32_u24 v6, 1056, v6
    v_and_b32 v7, 1, v3
    v_lshl_add_u32 v7, v7, 2, v2
    v_lshl_add_u32 v6, v7, 4, v6
    s_lshl_b32 s55, s54, 7
    s_add_u32 s55, s55, 138048
    v_add_u32 v6, s55, v6
    s_waitcnt lgkmcnt(0)
    ds_write_b32 v252, v253 offset:80
    s_mul_i32 s31, s14, 0x9e3779b1
    s_add_u32 s31, s31, 0x7f4a7c18
    s_andn2_b32 s31, s31, 7
    s_mov_b32 s46, 0
L_spin_x:
    ds_read_b32 v5, v4
    s_waitcnt lgkmcnt(0)
    v_cmp_ne_u32 vcc, 0, v5
    s_and_b32 s57, vcc_lo, 0xf00000
    s_cmp_eq_u32 s57, 0xf00000
    s_cbranch_scc1 L_spin_x_done
    s_sleep 2
    s_add_u32 s46, s46, 1
    s_cmp_lt_u32 s46, 524288
    s_cbranch_scc1 L_spin_x
L_spin_x_done:
    ds_read_b128 v[24:27], v6
    s_waitcnt vmcnt(1) lgkmcnt(0)
    v_perm_b32 v72, v44, v40, s44
    v_perm_b32 v73, v52, v48, s44
    v_perm_b32 v74, v60, v56, s44
    v_perm_b32 v75, v68, v64, s44
    v_perm_b32 v76, v44, v40, s45
    v_perm_b32 v77, v52, v48, s45
    v_perm_b32 v78, v60, v56, s45
    v_perm_b32 v79, v68, v64, s45
    v_mfma_f32_16x16x32_bf16 v[104:107], v[24:27], v[72:75], 0
    v_perm_b32 v80, v45, v41, s44
    v_perm_b32 v81, v53, v49, s44
    v_perm_b32 v82, v61, v57, s44
    v_perm_b32 v83, v69, v65, s44
    v_mfma_f32_16x16x32_bf16 v[108:111], v[24:27], v[76:79], 0
    v_perm_b32 v84, v45, v41, s45
    v_perm_b32 v85, v53, v49, s45
    v_perm_b32 v86, v61, v57, s45
    v_perm_b32 v87, v69, v65, s45
    v_mfma_f32_16x16x32_bf16 v[112:115], v[24:27], v[80:83], 0
    v_perm_b32 v88, v46, v42, s44
    v_perm_b32 v89, v54, v50, s44
    v_perm_b32 v90, v62, v58, s44
    v_perm_b32 v91, v70, v66, s44
    v_mfma_f32_16x16x32_bf16 v[116:119], v[24:27], v[84:87], 0
    v_perm_b32 v92, v46, v42, s45
    v_perm_b32 v93, v54, v50, s45
    v_perm_b32 v94, v62, v58, s45
    v_perm_b32 v95, v70, v66, s45
    v_mfma_f32_16x16x32_bf16 v[120:123], v[24:27], v[88:91], 0
    v_perm_b32 v96, v47, v43, s44
    v_perm_b32 v97, v55, v51, s44
    v_perm_b32 v98, v63, v59, s44
    v_perm_b32 v99, v71, v67, s44
    v_mfma_f32_16x16x32_bf16 v[124:127], v[24:27], v[92:95], 0
    v_perm_b32 v100, v47, v43, s45
    v_perm_b32 v101, v55, v51, s45
    v_perm_b32 v102, v63, v59, s45
    v_perm_b32 v103, v71, v67, s45
    v_mfma_f32_16x16x32_bf16 v[128:131], v[24:27], v[96:99], 0
    s_nop 1
    v_mfma_f32_16x16x32_bf16 v[132:135], v[24:27], v[100:103], 0
    v_lshlrev_b32 v5, 4, v3
    v_lshl_add_u32 v240, v2, 15, v5
    s_lshl_b32 s55, s28, 10
    s_add_u32 s55, s55, 146240
    v_add_u32 v6, s55, v241
    s_nop 1
    v_add_f32_dpp v8, v105, v104 row_ror:8 row_mask:0xf bank_mask:0x3
    v_add_f32_dpp v9, v109, v108 row_ror:8 row_mask:0xf bank_mask:0x3
    v_add_f32_dpp v10, v113, v112 row_ror:8 row_mask:0xf bank_mask:0x3
    v_add_f32_dpp v11, v117, v116 row_ror:8 row_mask:0xf bank_mask:0x3
    v_add_f32_dpp v8, v120, v121 row_ror:8 row_mask:0xf bank_mask:0xc
    v_add_f32_dpp v9, v124, v125 row_ror:8 row_mask:0xf bank_mask:0xc
    v_add_f32_dpp v10, v128, v129 row_ror:8 row_mask:0xf bank_mask:0xc
    v_add_f32_dpp v11, v132, v133 row_ror:8 row_mask:0xf bank_mask:0xc
    s_lshr_b32 s50, s30, 3
    s_lshl2_add_u32 s47, s29, s50
    s_getreg_b32 s66, hwreg(HW_REG_XCC_ID, 0, 3)
    s_or_b32 s66, s66, s31
    s_lshl_b32 s51, s30, 7
    v_add_u32 v248, s51, v241
    s_movk_i32 s51, 14336
    v_mad_u32_u24 v243, v2, s51, v5
    s_cmp_eq_u32 s28, 0
    s_cbranch_scc1 L_pw0
    ds_write_b128 v6, v[8:11]
    s_waitcnt lgkmcnt(0)
    ds_write_b32 v252, v253 offset:96
    s_mov_b32 s46, 0
L_spin_go:
    ds_read_b32 v5, v4
    s_waitcnt lgkmcnt(0)
    v_cmp_ne_u32 vcc, 0, v5
    s_and_b32 s57, vcc_lo, 0x100
    s_cmp_eq_u32 s57, 0x100
    s_cbranch_scc1 L_spin_go_done
    s_sleep 2
    s_add_u32 s46, s46, 1
    s_cmp_lt_u32 s46, 524288
    s_cbranch_scc1 L_spin_go
L_spin_go_done:
    s_branch L_go
L_pw0:
    s_mov_b32 s46, 0
L_spin_d:
    ds_read_b32 v5, v4
    s_waitcnt lgkmcnt(0)
    v_cmp_ne_u32 vcc, 0, v5
    s_and_b32 s57, vcc_lo, 0xe000000
    s_cmp_eq_u32 s57, 0xe000000
    s_cbranch_scc1 L_spin_d_done
    s_sleep 2
    s_add_u32 s46, s46, 1
    s_cmp_lt_u32 s46, 524288
    s_cbranch_scc1 L_spin_d
L_spin_d_done:
    ds_read_b128 v[12:15], v6 offset:1024
    ds_read_b128 v[16:19], v6 offset:2048
    ds_read_b128 v[20:23], v6 offset:3072
    v_mov_b32 v225, s31
    v_mov_b32 v227, s31
    v_mov_b32 v229, s31
    v_mov_b32 v231, s31
    v_mov_b32 v233, s31
    v_mov_b32 v235, s31
    v_mov_b32 v237, s31
    v_mov_b32 v239, s31
    v_mov_b32 v244, s66
    v_mov_b32 v245, s66
    v_mov_b32 v246, s66
    v_mov_b32 v247, s66
    s_waitcnt lgkmcnt(0)
    v_add_f32 v224, v8, v12
    v_add_f32 v226, v9, v13
    v_add_f32 v228, v10, v14
    v_add_f32 v230, v11, v15
    v_add_f32 v232, v16, v20
    v_add_f32 v234, v17, v21
    v_add_f32 v236, v18, v22
    v_add_f32 v238, v19, v23
    v_add_f32 v224, v224, v232
    v_add_f32 v226, v226, v234
    v_add_f32 v228, v228, v236
    v_add_f32 v230, v230, v238
    s_bitcmp1_b32 s30, 2
    s_cbranch_scc1 L_gsa
    buffer_store_dwordx4 v[224:227], v240, s[32:35], s3 offen
    buffer_store_dwordx4 v[228:231], v240, s[32:35], s3 offen offset:256
    s_branch L_nogsa
L_gsa:
    s_cmp_lt_i32 s49, 0
    s_cbranch_scc1 L_nogsa
    buffer_store_dwordx4 v[224:227], v243, s[32:35], s24 offen
    buffer_store_dwordx4 v[228:231], v243, s[32:35], s24 offen offset:256
L_nogsa:
    s_mov_b64 exec, 15
    buffer_store_dwordx4 v[244:247], v248, s[32:35], s65 offen
    s_mov_b64 exec, -1
    s_waitcnt vmcnt(0)
    ds_write_b32 v252, v253 offset:32
L_go:
    v_and_b32 v249, 31, v0
    v_lshlrev_b32 v249, 7, v249
    s_lshl_b32 s51, s50, 15
    s_lshl_b32 s52, s29, 12
    s_add_u32 s51, s51, s52
    s_lshl_b32 s52, s28, 10
    s_add_u32 s51, s51, s52
    s_add_u32 s51, s51, 4096
    s_add_u32 s52, s51, 131072
    s_mov_b32 s46, 0
    s_mov_b32 s15, 0
    v_mov_b32 v24, s66
L_qpoll:
    buffer_load_dwordx4 v[8:11], v241, s[32:35], s51 offen sc1 nt
    buffer_load_dwordx4 v[12:15], v241, s[32:35], s52 offen sc1 nt
    s_cmp_eq_u32 s28, 0
    s_cbranch_scc0 L_qnp
    buffer_load_dword v24, v249, s[32:35], s65 offen sc1 nt
L_qnp:
    s_waitcnt vmcnt(0)
    v_bitop3_b32 v9, v9, v11, s31 bitop3:0x7e
    v_bitop3_b32 v13, v13, v15, s31 bitop3:0x7e
    v_xor_b32 v25, s66, v24
    v_or3_b32 v26, v9, v13, v25
    v_cmp_ne_u32 vcc, 0, v26
    s_cbranch_vccz L_qok
    s_add_u32 s46, s46, 1
    s_cmp_eq_u32 s28, 0
    s_cbranch_scc0 L_qretry
    v_add_u32 v27, -1, v25
    v_cmp_gt_u32 vcc, 7, v27
    s_cbranch_vccnz L_qrepub
    s_cmp_lt_u32 s46, 12
    s_cbranch_scc1 L_qretry
L_qrepub:
    s_cmp_eq_u32 s15, 0
    s_cbranch_scc0 L_qchk
    s_mov_b32 s15, 2
    s_mov_b64 exec, 15
    buffer_store_dwordx4 v[244:247], v248, s[32:35], s65 offen sc1
    s_mov_b64 exec, -1
    s_bitcmp1_b32 s30, 2
    s_cbranch_scc1 L_gsb
    buffer_store_dwordx4 v[224:227], v240, s[32:35], s3 offen sc1
    buffer_store_dwordx4 v[228:231], v240, s[32:35], s3 offen offset:256 sc1
    s_branch L_nogsb
L_gsb:
    s_cmp_lt_i32 s49, 0
    s_cbranch_scc1 L_nogsb
    buffer_store_dwordx4 v[224:227], v243, s[32:35], s24 offen sc1
    buffer_store_dwordx4 v[228:231], v243, s[32:35], s24 offen offset:256 sc1
L_nogsb:
L_qchk:
    v_and_b32 v25, -8, v25
    v_or3_b32 v26, v9, v13, v25
    v_cmp_ne_u32 vcc, 0, v26
    s_cbranch_vccz L_qok
L_qretry:
    s_sleep 1
    s_cmp_lt_u32 s46, 65536
    s_cbranch_scc1 L_qpoll
L_qok:
    v_add_f32 v8, v8, v12
    v_add_f32 v10, v10, v14
    v_cvt_pk_bf16_f32 v8, v8, v10
    s_mul_i32 s51, s28, 320
    s_add_u32 s51, s51, 131072
    v_and_b32 v6, 32, v0
    v_and_b32 v7, 7, v0
    v_lshl_add_u32 v6, v7, 2, v6
    v_bfe_u32 v7, v0, 3, 1
    v_lshl_add_u32 v6, v7, 1, v6
    v_and_b32 v7, 1, v2
    v_add_u32 v6, v6, v7
    v_lshl_add_u32 v6, v6, 2, s51
    ds_write_b32 v6, v8
    s_or_b32 s52, s15, 1
    v_mov_b32 v7, s52
    s_waitcnt lgkmcnt(0)
    ds_write_b32 v252, v7 offset:16
    s_lshl_b32 s99, s29, 5
    s_add_u32 s99, s99, s30
    v_and_b32 v5, 3, v0
    v_lshlrev_b32 v251, 2, v5
    s_cmp_eq_u32 s28, 2
    s_cbranch_scc0 L_nox
    s_lshl_b32 s51, s99, 4
    buffer_load_dword v250, v251, s[40:43], s51 offen
L_nox:
    v_lshrrev_b32 v5, 2, v0
    s_movk_i32 s51, 14336
    v_mul_lo_u32 v5, v5, s51
    v_and_b32 v6, 3, v0
    v_lshl_add_u32 v216, v6, 4, v5
    s_max_i32 s51, s49, 0
    s_lshl_b32 s67, s51, 9
    s_lshl_b32 s51, s28, 6
    s_add_u32 s67, s67, s51
    s_add_u32 s67, s67, 528384
    s_add_u32 s25, s67, 229376
    s_cmp_lt_i32 s49, 0
    s_cbranch_scc1 L_nogu
    buffer_load_dwordx4 v[192:195], v216, s[32:35], s67 offen offset:0 sc1 nt
    s_waitcnt vmcnt(0)
    buffer_load_dwordx4 v[196:199], v216, s[32:35], s67 offen offset:256 sc1 nt
L_nogu:
    v_lshlrev_b32 v5, 3, v3
    v_lshl_add_u32 v220, v2, 15, v5
    v_lshl_add_u32 v221, v2, 13, v5
    s_lshl_b32 s50, s47, 17
    s_lshl_b32 s57, s28, 11
    s_add_u32 s50, s50, s57
    s_lshl_b32 s57, s48, 7
    s_add_u32 s50, s50, s57
    s_max_i32 s52, s49, 0
    s_lshl_b32 s52, s52, 16
    s_add_u32 s52, s52, s57
    s_and_b32 s57, s28, 1
    s_lshl_b32 s57, s57, 15
    s_add_u32 s52, s52, s57
    s_lshr_b32 s57, s28, 1
    s_lshl_b32 s57, s57, 12
    s_add_u32 s52, s52, s57
    s_mov_b32 s36, s12
    s_and_b32 s37, s13, 0xffff
    s_mov_b32 s38, 4194304
    s_mov_b32 s39, 0x20000
    s_mov_b32 s40, s20
    s_and_b32 s41, s21, 0xffff
    s_mov_b32 s43, 0x20000
    s_cmp_lt_i32 s49, 0
    s_cselect_b32 s42, 0, 1835008
    v_and_b32 v5, 7, v3
    v_lshlrev_b32 v5, 4, v5
    v_lshl_add_u32 v222, v2, 7, v5
    s_lshl_b32 s53, s47, 9
    s_add_u32 s53, s53, 1019904
    s_lshl_b32 s54, s47, 14
    s_lshl_b32 s57, s28, 12
    s_add_u32 s54, s54, s57
    s_add_u32 s54, s54, 1036288
    s_lshl_b32 s57, s28, 10
    s_add_u32 s57, s57, 146240
    v_add_u32 v223, s57, v241
    s_lshl_b32 s57, s28, 9
    s_add_u32 s57, s57, 146240
    v_lshl_add_u32 v217, v0, 3, s57
    v_lshrrev_b32 v5, 5, v0
    v_lshlrev_b32 v5, 17, v5
    v_bfe_u32 v6, v0, 2, 3
    v_lshl_add_u32 v5, v6, 11, v5
    v_and_b32 v6, 3, v0
    v_lshl_add_u32 v166, v6, 4, v5
    s_lshl_b32 s55, s28, 18
    s_lshl_b32 s57, s48, 14
    s_add_u32 s55, s55, s57
    s_lshl_b32 s57, s47, 6
    s_add_u32 s55, s55, s57
    s_add_u32 s55, s55, 1560576
    v_mov_b32 v167, 0
    s_lshl_b32 s51, 1, s28
    s_or_b32 s51, s51, 0xf0
    s_mov_b32 s46, 0
L_spin_kq:
    ds_read_b32 v5, v4
    s_waitcnt lgkmcnt(0)
    v_cmp_ne_u32 vcc, 0, v5
    s_and_b32 s57, vcc_lo, s51
    s_cmp_eq_u32 s57, s51
    s_cbranch_scc1 L_spin_kq_done
    s_sleep 2
    s_add_u32 s46, s46, 1
    s_cmp_lt_u32 s46, 524288
    s_cbranch_scc1 L_spin_kq
L_spin_kq_done:
    v_readlane_b32 s15, v5, 4
    s_and_b32 s15, s15, 2
    v_and_b32 v5, 3, v3
    v_mul_u32_u24 v5, 320, v5
    v_lshl_add_u32 v5, v2, 4, v5
    v_add_u32 v6, 131072, v5
    v_lshrrev_b32 v7, 2, v3
    v_mov_b32 v144, 132352
    v_cmp_eq_u32 vcc, 0, v7
    s_nop 1
    v_cndmask_b32 v140, v144, v6, vcc
    v_cmp_eq_u32 vcc, 1, v7
    s_nop 1
    v_cndmask_b32 v141, v144, v6, vcc
    v_cmp_eq_u32 vcc, 2, v7
    s_nop 1
    v_cndmask_b32 v142, v144, v6, vcc
    v_cmp_eq_u32 vcc, 3, v7
    s_nop 1
    v_cndmask_b32 v143, v144, v6, vcc
    ds_read_b128 v[8:11], v140 offset:0
    ds_read_b128 v[12:15], v140 offset:64
    ds_read_b128 v[16:19], v140 offset:128
    ds_read_b128 v[20:23], v140 offset:192
    ds_read_b128 v[24:27], v141 offset:0
    ds_read_b128 v[28:31], v141 offset:64
    ds_read_b128 v[32:35], v141 offset:128
    ds_read_b128 v[36:39], v141 offset:192
    s_waitcnt lgkmcnt(4)
    ds_read_b128 v[40:43], v142 offset:0
    ds_read_b128 v[44:47], v142 offset:64
    ds_read_b128 v[48:51], v142 offset:128
    ds_read_b128 v[52:55], v142 offset:192
    ds_read_b128 v[56:59], v143 offset:0
    ds_read_b128 v[60:63], v143 offset:64
    ds_read_b128 v[64:67], v143 offset:128
    ds_read_b128 v[68:71], v143 offset:192
    v_and_b32 v6, 3, v3
    v_lshl_add_u32 v6, v6, 2, v7
    v_lshlrev_b32 v6, 8, v6
    s_lshl_b32 s51, s28, 15
    v_add_u32 v6, s51, v6
    v_xor_b32 v7, v2, v3
    v_xor_b32 v146, 0, v7
    v_lshl_add_u32 v146, v146, 4, v6
    v_xor_b32 v147, 4, v7
    v_lshl_add_u32 v147, v147, 4, v6
    v_xor_b32 v148, 8, v7
    v_lshl_add_u32 v148, v148, 4, v6
    v_xor_b32 v149, 12, v7
    v_lshl_add_u32 v149, v149, 4, v6
    s_waitcnt lgkmcnt(0)
    ds_read_b128 v[72:75], v146 offset:0
    ds_read_b128 v[76:79], v147 offset:0
    ds_read_b128 v[80:83], v148 offset:0
    ds_read_b128 v[84:87], v149 offset:0
    ds_read_b128 v[88:91], v146 offset:4096
    ds_read_b128 v[92:95], v147 offset:4096
    ds_read_b128 v[96:99], v148 offset:4096
    ds_read_b128 v[100:103], v149 offset:4096
    ds_read_b128 v[104:107], v146 offset:8192
    ds_read_b128 v[108:111], v147 offset:8192
    ds_read_b128 v[112:115], v148 offset:8192
    ds_read_b128 v[116:119], v149 offset:8192
    s_waitcnt lgkmcnt(11)
    v_mfma_f32_16x16x32_bf16 v[152:155], v[72:75], v[8:11], 0
    ds_read_b128 v[120:123], v146 offset:12288
    s_waitcnt lgkmcnt(11)
    v_mfma_f32_16x16x32_bf16 v[152:155], v[76:79], v[12:15], v[152:155]
    ds_read_b128 v[124:127], v147 offset:12288
    s_waitcnt lgkmcnt(11)
    v_mfma_f32_16x16x32_bf16 v[152:155], v[80:83], v[16:19], v[152:155]
    ds_read_b128 v[128:131], v148 offset:12288
    s_waitcnt lgkmcnt(11)
    v_mfma_f32_16x16x32_bf16 v[152:155], v[84:87], v[20:23], v[152:155]
    ds_read_b128 v[132:135], v149 offset:12288
    s_waitcnt lgkmcnt(11)
    v_mfma_f32_16x16x32_bf16 v[156:159], v[88:91], v[8:11], 0
    ds_read_b128 v[72:75], v146 offset:16384
    s_waitcnt lgkmcnt(11)
    v_mfma_f32_16x16x32_bf16 v[156:159], v[92:95], v[12:15], v[156:159]
    ds_read_b128 v[76:79], v147 offset:16384
    s_waitcnt lgkmcnt(11)
    v_mfma_f32_16x16x32_bf16 v[156:159], v[96:99], v[16:19], v[156:159]
    ds_read_b128 v[80:83], v148 offset:16384
    s_waitcnt lgkmcnt(11)
    v_mfma_f32_16x16x32_bf16 v[156:159], v[100:103], v[20:23], v[156:159]
    ds_read_b128 v[84:87], v149 offset:16384
    s_waitcnt lgkmcnt(11)
    v_mfma_f32_16x16x32_bf16 v[152:155], v[104:107], v[24:27], v[152:155]
    ds_read_b128 v[88:91], v146 offset:20480
    s_waitcnt lgkmcnt(11)
    v_mfma_f32_16x16x32_bf16 v[152:155], v[108:111], v[28:31], v[152:155]
    ds_read_b128 v[92:95], v147 offset:20480
    s_waitcnt lgkmcnt(11)
    v_mfma_f32_16x16x32_bf16 v[152:155], v[112:115], v[32:35], v[152:155]
    ds_read_b128 v[96:99], v148 offset:20480
    s_waitcnt lgkmcnt(11)
    v_mfma_f32_16x16x32_bf16 v[152:155], v[116:119], v[36:39], v[152:155]
    ds_read_b128 v[100:103], v149 offset:20480
    s_waitcnt lgkmcnt(11)
    v_mfma_f32_16x16x32_bf16 v[156:159], v[120:123], v[24:27], v[156:159]
    ds_read_b128 v[104:107], v146 offset:24576
    s_waitcnt lgkmcnt(11)
    v_mfma_f32_16x16x32_bf16 v[156:159], v[124:127], v[28:31], v[156:159]
    ds_read_b128 v[108:111], v147 offset:24576
    s_waitcnt lgkmcnt(11)
    v_mfma_f32_16x16x32_bf16 v[156:159], v[128:131], v[32:35], v[156:159]
    ds_read_b128 v[112:115], v148 offset:24576
    s_waitcnt lgkmcnt(11)
    v_mfma_f32_16x16x32_bf16 v[156:159], v[132:135], v[36:39], v[156:159]
    ds_read_b128 v[116:119], v149 offset:24576
    s_waitcnt lgkmcnt(11)
    v_mfma_f32_16x16x32_bf16 v[152:155], v[72:75], v[40:43], v[152:155]
    ds_read_b128 v[120:123], v146 offset:28672
    s_waitcnt lgkmcnt(11)
    v_mfma_f32_16x16x32_bf16 v[152:155], v[76:79], v[44:47], v[152:155]
    ds_read_b128 v[124:127], v147 offset:28672
    s_waitcnt lgkmcnt(11)
    v_mfma_f32_16x16x32_bf16 v[152:155], v[80:83], v[48:51], v[152:155]
    ds_read_b128 v[128:131], v148 offset:28672
    s_waitcnt lgkmcnt(11)
    v_mfma_f32_16x16x32_bf16 v[152:155], v[84:87], v[52:55], v[152:155]
    ds_read_b128 v[132:135], v149 offset:28672
    s_waitcnt lgkmcnt(11)
    v_mfma_f32_16x16x32_bf16 v[156:159], v[88:91], v[40:43], v[156:159]
    s_waitcnt lgkmcnt(10)
    v_mfma_f32_16x16x32_bf16 v[156:159], v[92:95], v[44:47], v[156:159]
    s_waitcnt lgkmcnt(9)
    v_mfma_f32_16x16x32_bf16 v[156:159], v[96:99], v[48:51], v[156:159]
    s_waitcnt lgkmcnt(8)
    v_mfma_f32_16x16x32_bf16 v[156:159], v[100:103], v[52:55], v[156:159]
    s_waitcnt lgkmcnt(7)
    v_mfma_f32_16x16x32_bf16 v[152:155], v[104:107], v[56:59], v[152:155]
    s_waitcnt lgkmcnt(6)
    v_mfma_f32_16x16x32_bf16 v[152:155], v[108:111], v[60:63], v[152:155]
    s_waitcnt lgkmcnt(5)
    v_mfma_f32_16x16x32_bf16 v[152:155], v[112:115], v[64:67], v[152:155]
    s_waitcnt lgkmcnt(4)
    v_mfma_f32_16x16x32_bf16 v[152:155], v[116:119], v[68:71], v[152:155]
    s_waitcnt lgkmcnt(3)
    v_mfma_f32_16x16x32_bf16 v[156:159], v[120:123], v[56:59], v[156:159]
    s_waitcnt lgkmcnt(2)
    v_mfma_f32_16x16x32_bf16 v[156:159], v[124:127], v[60:63], v[156:159]
    s_waitcnt lgkmcnt(1)
    v_mfma_f32_16x16x32_bf16 v[156:159], v[128:131], v[64:67], v[156:159]
    s_waitcnt lgkmcnt(0)
    v_mfma_f32_16x16x32_bf16 v[156:159], v[132:135], v[68:71], v[156:159]
    s_nop 7
    s_mov_b32 s51, 0x3db504f3
    s_mov_b32 s57, 0x3fb8aa3b
    v_cvt_pk_bf16_f32 v160, v152, v153
    v_cvt_pk_bf16_f32 v161, v154, v155
    v_cvt_pk_bf16_f32 v162, v156, v157
    v_cvt_pk_bf16_f32 v163, v158, v159
    v_lshlrev_b32 v152, 16, v160
    v_and_b32 v153, 0xffff0000, v160
    v_lshlrev_b32 v154, 16, v161
    v_and_b32 v155, 0xffff0000, v161
    v_lshlrev_b32 v156, 16, v162
    v_and_b32 v157, 0xffff0000, v162
    v_lshlrev_b32 v158, 16, v163
    v_and_b32 v159, 0xffff0000, v163
    v_mul_f32 v152, s51, v152
    v_mul_f32 v153, s51, v153
    v_mul_f32 v154, s51, v154
    v_mul_f32 v155, s51, v155
    v_mul_f32 v156, s51, v156
    v_mul_f32 v157, s51, v157
    v_mul_f32 v158, s51, v158
    v_mul_f32 v159, s51, v159
    v_cvt_pk_bf16_f32 v160, v152, v153
    v_cvt_pk_bf16_f32 v161, v154, v155
    v_cvt_pk_bf16_f32 v162, v156, v157
    v_cvt_pk_bf16_f32 v163, v158, v159
    v_lshlrev_b32 v152, 16, v160
    v_and_b32 v153, 0xffff0000, v160
    v_lshlrev_b32 v154, 16, v161
    v_and_b32 v155, 0xffff0000, v161
    v_lshlrev_b32 v156, 16, v162
    v_and_b32 v157, 0xffff0000, v162
    v_lshlrev_b32 v158, 16, v163
    v_and_b32 v159, 0xffff0000, v163
    v_max3_f32 v164, v152, v153, v154
    v_max3_f32 v165, v155, v156, v157
    v_max3_f32 v164, v164, v158, v159
    v_max_f32 v164, v164, v165
    s_nop 1
    v_max_f32_dpp v164, v164, v164 row_ror:4 row_mask:0xf bank_mask:0xf
    s_nop 1
    v_max_f32_dpp v164, v164, v164 row_ror:8 row_mask:0xf bank_mask:0xf
    v_mov_b32 v5, v164
    s_nop 1
    v_permlane16_swap_b32 v164, v5
    s_nop 0
    v_max_f32 v164, v164, v5
    v_mov_b32 v5, v164
    s_nop 1
    v_permlane32_swap_b32 v164, v5
    s_nop 0
    v_max_f32 v164, v164, v5
    v_sub_f32 v152, v152, v164
    v_sub_f32 v153, v153, v164
    v_sub_f32 v154, v154, v164
    v_sub_f32 v155, v155, v164
    v_sub_f32 v156, v156, v164
    v_sub_f32 v157, v157, v164
    v_sub_f32 v158, v158, v164
    v_sub_f32 v159, v159, v164
    v_mul_f32 v152, s57, v152
    v_mul_f32 v153, s57, v153
    v_mul_f32 v154, s57, v154
    v_mul_f32 v155, s57, v155
    v_mul_f32 v156, s57, v156
    v_mul_f32 v157, s57, v157
    v_mul_f32 v158, s57, v158
    v_mul_f32 v159, s57, v159
    v_exp_f32 v152, v152
    v_exp_f32 v153, v153
    v_exp_f32 v154, v154
    v_exp_f32 v155, v155
    v_exp_f32 v156, v156
    v_exp_f32 v157, v157
    v_exp_f32 v158, v158
    v_exp_f32 v159, v159
    s_nop 0
    v_cvt_pk_bf16_f32 v160, v152, v153
    v_cvt_pk_bf16_f32 v161, v154, v155
    v_cvt_pk_bf16_f32 v162, v156, v157
    v_cvt_pk_bf16_f32 v163, v158, v159
    v_add_f32 v165, v152, v153
    v_add_f32 v5, v154, v155
    v_add_f32 v6, v156, v157
    v_add_f32 v7, v158, v159
    v_add_f32 v165, v165, v5
    v_add_f32 v6, v6, v7
    v_add_f32 v165, v165, v6
    v_and_b32 v5, 3, v3
    v_mul_u32_u24 v6, 320, v5
    v_lshl_add_u32 v6, v2, 4, v6
    v_and_b32 v7, 12, v3
    v_lshl_add_u32 v6, v7, 4, v6
    s_mul_i32 s51, s28, 1280
    s_add_u32 s51, s51, 132928
    v_add_u32 v6, s51, v6
    ds_write_b128 v6, v[160:163]
    s_nop 1
    v_add_f32_dpp v165, v165, v165 row_ror:4 row_mask:0xf bank_mask:0xf
    s_nop 1
    v_add_f32_dpp v165, v165, v165 row_ror:8 row_mask:0xf bank_mask:0xf
    v_mov_b32 v7, v165
    s_nop 1
    v_permlane16_swap_b32 v165, v7
    s_nop 0
    v_add_f32 v165, v165, v7
    v_mov_b32 v7, v165
    s_nop 1
    v_permlane32_swap_b32 v165, v7
    s_nop 0
    v_add_f32 v165, v165, v7
    s_lshl_b32 s51, s28, 2
    s_add_u32 s51, s51, 132736
    v_lshl_add_u32 v6, v5, 4, s51
    s_lshl_b32 s51, s28, 4
    s_add_u32 s51, s51, 132864
    v_lshl_add_u32 v7, v5, 2, s51
    ds_write_b32 v6, v164
    ds_write_b32 v6, v165 offset:64
    ds_write_b32 v7, v164
    s_waitcnt vmcnt(0) lgkmcnt(0)
    ds_write_b32 v252, v253 offset:36
    s_cmp_eq_u32 s28, 3
    s_cbranch_scc0 L_nostat
    s_mov_b32 s46, 0
L_spin_st:
    ds_read_b32 v5, v4
    s_waitcnt lgkmcnt(0)
    v_cmp_ne_u32 vcc, 0, v5
    s_and_b32 s57, vcc_lo, 0x1e00
    s_cmp_eq_u32 s57, 0x1e00
    s_cbranch_scc1 L_spin_st_done
    s_sleep 2
    s_add_u32 s46, s46, 1
    s_cmp_lt_u32 s46, 524288
    s_cbranch_scc1 L_spin_st
L_spin_st_done:
    v_and_b32 v5, 3, v0
    v_lshlrev_b32 v5, 4, v5
    v_add_u32 v6, 132736, v5
    ds_read_b128 v[8:11], v6
    ds_read_b128 v[12:15], v6 offset:64
    s_mov_b32 s57, 0x3fb8aa3b
    s_waitcnt lgkmcnt(0)
    v_max3_f32 v16, v8, v9, v10
    v_max_f32 v16, v16, v11
    v_sub_f32 v8, v8, v16
    v_sub_f32 v9, v9, v16
    v_sub_f32 v10, v10, v16
    v_sub_f32 v11, v11, v16
    v_mul_f32 v8, s57, v8
    v_mul_f32 v9, s57, v9
    v_mul_f32 v10, s57, v10
    v_mul_f32 v11, s57, v11
    v_exp_f32 v8, v8
    v_exp_f32 v9, v9
    v_exp_f32 v10, v10
    v_exp_f32 v11, v11
    v_mov_b32 v17, s31
    v_mov_b32 v19, s31
    v_mul_f32 v18, v8, v12
    v_fmac_f32 v18, v9, v13
    v_fmac_f32 v18, v10, v14
    v_fmac_f32 v18, v11, v15
    v_lshlrev_b32 v5, 5, v5
    s_lshl_b32 s57, s29, 11
    s_lshl_b32 s51, s30, 4
    s_add_u32 s57, s57, s51
    s_add_u32 s57, s57, 1019904
    s_mov_b64 exec, 15
    s_cmp_eq_u32 s15, 0
    s_cbranch_scc0 L_sm_st
    buffer_store_dwordx4 v[16:19], v5, s[32:35], s57 offen
    s_branch L_sm_st_done
L_sm_st:
    buffer_store_dwordx4 v[16:19], v5, s[32:35], s57 offen sc1
L_sm_st_done:
    s_mov_b64 exec, -1
L_nostat:
    v_mov_b32 v218, 0
    v_mov_b32 v219, 0
    s_cmp_lt_i32 s49, 0
    s_cbranch_scc1 L_noffn
    s_mov_b32 s46, 0
L_gupoll:
    v_bitop3_b32 v193, v193, v195, s31 bitop3:0x7e
    v_bitop3_b32 v197, v197, v199, s31 bitop3:0x7e
    v_or_b32 v193, v193, v197
    v_cmp_ne_u32 vcc, 0, v193
    s_cbranch_vccz L_guok
    s_add_u32 s46, s46, 1
    s_cmp_lt_u32 s46, 65536
    s_cbranch_scc0 L_guok
    buffer_load_dwordx4 v[192:195], v216, s[32:35], s67 offen offset:0 sc1 nt
    s_waitcnt vmcnt(0)
    buffer_load_dwordx4 v[196:199], v216, s[32:35], s67 offen offset:256 sc1 nt
    s_waitcnt vmcnt(0)
    s_branch L_gupoll
L_guok:
    v_mov_b32 v193, v192
    v_mov_b32 v195, v194
    v_mov_b32 v197, v196
    v_mov_b32 v199, v198
    v_permlane16_swap_b32 v192, v193
    v_permlane16_swap_b32 v194, v195
    v_permlane16_swap_b32 v196, v197
    v_permlane16_swap_b32 v198, v199
    v_add_f32 v208, v192, v193
    v_add_f32 v209, v194, v195
    v_add_f32 v210, v196, v197
    v_add_f32 v211, v198, v199
    v_cvt_pk_bf16_f32 v208, v208, v208
    v_cvt_pk_bf16_f32 v209, v209, v209
    v_cvt_pk_bf16_f32 v210, v210, v210
    v_cvt_pk_bf16_f32 v211, v211, v211
    v_and_b32 v208, 0xffff0000, v208
    v_and_b32 v209, 0xffff0000, v209
    v_and_b32 v210, 0xffff0000, v210
    v_and_b32 v211, 0xffff0000, v211
    v_mov_b32 v212, v208
    v_mov_b32 v213, v209
    v_mov_b32 v214, v210
    v_mov_b32 v215, v211
    v_permlane32_swap_b32 v208, v212
    v_permlane32_swap_b32 v209, v213
    v_permlane32_swap_b32 v210, v214
    v_permlane32_swap_b32 v211, v215
    s_mov_b32 s57, 0xbfb8aa3b
    v_mul_f32 v192, s57, v208
    v_mul_f32 v194, s57, v209
    v_mul_f32 v196, s57, v210
    v_mul_f32 v198, s57, v211
    v_exp_f32 v192, v192
    v_exp_f32 v194, v194
    v_exp_f32 v196, v196
    v_exp_f32 v198, v198
    s_nop 0
    v_add_f32 v192, 1.0, v192
    v_add_f32 v194, 1.0, v194
    v_add_f32 v196, 1.0, v196
    v_add_f32 v198, 1.0, v198
    v_rcp_f32 v192, v192
    v_rcp_f32 v194, v194
    v_rcp_f32 v196, v196
    v_rcp_f32 v198, v198
    s_nop 0
    v_mul_f32 v208, v208, v192
    v_mul_f32 v209, v209, v194
    v_mul_f32 v210, v210, v196
    v_mul_f32 v211, v211, v198
    v_cvt_pk_bf16_f32 v208, v208, v208
    v_cvt_pk_bf16_f32 v209, v209, v209
    v_cvt_pk_bf16_f32 v210, v210, v210
    v_cvt_pk_bf16_f32 v211, v211, v211
    v_and_b32 v208, 0xffff0000, v208
    v_and_b32 v209, 0xffff0000, v209
    v_and_b32 v210, 0xffff0000, v210
    v_and_b32 v211, 0xffff0000, v211
    v_mul_f32 v208, v208, v212
    v_mul_f32 v209, v209, v213
    v_mul_f32 v210, v210, v214
    v_mul_f32 v211, v211, v215
    v_and_b32 v5, 3, v0
    v_cmp_eq_u32 vcc, v5, v2
    v_cvt_pk_bf16_f32 v208, v208, v209
    v_cvt_pk_bf16_f32 v209, v210, v211
    v_cndmask_b32 v218, v218, v208, vcc
    v_cndmask_b32 v219, v219, v209, vcc
L_noffn:
    s_barrier
    buffer_load_dwordx4 v[48:51], v222, s[32:35], s53 offen sc1 nt
    buffer_load_dwordx2 v[184:185], v221, s[40:43], s52 offen offset:0 nt
    buffer_load_dwordx2 v[186:187], v221, s[40:43], s52 offen offset:1024 nt
    buffer_load_dwordx2 v[188:189], v221, s[40:43], s52 offen offset:2048 nt
    buffer_load_dwordx2 v[190:191], v221, s[40:43], s52 offen offset:3072 nt
    buffer_load_dwordx2 v[168:169], v220, s[36:39], s50 offen offset:0 nt
    buffer_load_dwordx2 v[170:171], v220, s[36:39], s50 offen offset:1024 nt
    s_add_u32 s50, s50, 8192
    buffer_load_dwordx2 v[172:173], v220, s[36:39], s50 offen offset:0 nt
    buffer_load_dwordx2 v[174:175], v220, s[36:39], s50 offen offset:1024 nt
    s_add_u32 s50, s50, 8192
    buffer_load_dwordx2 v[176:177], v220, s[36:39], s50 offen offset:0 nt
    buffer_load_dwordx2 v[178:179], v220, s[36:39], s50 offen offset:1024 nt
    s_add_u32 s50, s50, 8192
    buffer_load_dwordx2 v[180:181], v220, s[36:39], s50 offen offset:0 nt
    buffer_load_dwordx2 v[182:183], v220, s[36:39], s50 offen offset:1024 nt
    s_mov_b32 s40, s22
    s_and_b32 s41, s23, 0xffff
    s_mov_b32 s42, 4096
    s_mov_b32 s43, 0x20000
    s_barrier
    s_sleep 6
    buffer_load_dwordx4 v[52:55], v241, s[32:35], s54 offen offset:0 sc1 nt
    buffer_load_dwordx4 v[56:59], v241, s[32:35], s54 offen offset:1024 sc1 nt
    buffer_load_dwordx4 v[60:63], v241, s[32:35], s54 offen offset:2048 sc1 nt
    buffer_load_dwordx4 v[64:67], v241, s[32:35], s54 offen offset:3072 sc1 nt
    s_mov_b32 s46, 0
    s_waitcnt vmcnt(16)
L_stpoll:
    v_bitop3_b32 v49, v49, v51, s31 bitop3:0x7e
    v_cmp_ne_u32 vcc, 0, v49
    s_cbranch_vccz L_stok
    s_add_u32 s46, s46, 1
    s_cmp_lt_u32 s46, 65536
    s_cbranch_scc0 L_stok
    buffer_load_dwordx4 v[48:51], v222, s[32:35], s53 offen sc1 nt
    s_waitcnt vmcnt(0)
    s_branch L_stpoll
L_stok:
    s_mov_b32 s57, 0x3fb8aa3b
    v_mov_b32 v49, v48
    s_nop 1
    v_max_f32_dpp v49, v49, v49 quad_perm:[1,0,3,2] row_mask:0xf bank_mask:0xf
    s_nop 1
    v_max_f32_dpp v49, v49, v49 quad_perm:[2,3,0,1] row_mask:0xf bank_mask:0xf
    s_nop 1
    v_max_f32_dpp v49, v49, v49 row_ror:4 row_mask:0xf bank_mask:0xf
    v_sub_f32 v48, v48, v49
    v_mul_f32 v48, s57, v48
    v_exp_f32 v48, v48
    s_nop 0
    v_mul_f32 v50, v48, v50
    s_nop 1
    v_add_f32_dpp v50, v50, v50 quad_perm:[1,0,3,2] row_mask:0xf bank_mask:0xf
    s_nop 1
    v_add_f32_dpp v50, v50, v50 quad_perm:[2,3,0,1] row_mask:0xf bank_mask:0xf
    s_nop 1
    v_add_f32_dpp v50, v50, v50 row_ror:4 row_mask:0xf bank_mask:0xf
    v_rcp_f32 v50, v50
    s_nop 0
    v_mul_f32 v148, v48, v50
    s_waitcnt vmcnt(12)
    v_perm_b32 v88, v186, v184, s44
    v_perm_b32 v89, v190, v188, s44
    v_perm_b32 v90, v186, v184, s45
    v_perm_b32 v91, v190, v188, s45
    v_perm_b32 v92, v187, v185, s44
    v_perm_b32 v93, v191, v189, s44
    v_perm_b32 v94, v187, v185, s45
    v_perm_b32 v95, v191, v189, s45
    s_nop 0
    v_mfma_f32_16x16x16_bf16 v[96:99], v[218:219], v[88:89], 0
    v_mfma_f32_16x16x16_bf16 v[100:103], v[218:219], v[90:91], 0
    v_mfma_f32_16x16x16_bf16 v[104:107], v[218:219], v[92:93], 0
    v_mfma_f32_16x16x16_bf16 v[108:111], v[218:219], v[94:95], 0
    s_nop 6
    v_add_f32 v144, v96, v97
    v_add_f32 v145, v100, v101
    v_add_f32 v146, v104, v105
    v_add_f32 v147, v108, v109
    v_add_f32 v98, v98, v99
    v_add_f32 v102, v102, v103
    v_add_f32 v106, v106, v107
    v_add_f32 v110, v110, v111
    v_add_f32 v144, v144, v98
    v_add_f32 v145, v145, v102
    v_add_f32 v146, v146, v106
    v_add_f32 v147, v147, v110
    s_waitcnt vmcnt(4)
    v_perm_b32 v72, v170, v168, s44
    v_perm_b32 v73, v178, v176, s44
    v_perm_b32 v74, v174, v172, s44
    v_perm_b32 v75, v182, v180, s44
    v_perm_b32 v76, v170, v168, s45
    v_perm_b32 v77, v178, v176, s45
    v_perm_b32 v78, v174, v172, s45
    v_perm_b32 v79, v182, v180, s45
    v_perm_b32 v80, v171, v169, s44
    v_perm_b32 v81, v179, v177, s44
    v_perm_b32 v82, v175, v173, s44
    v_perm_b32 v83, v183, v181, s44
    v_perm_b32 v84, v171, v169, s45
    v_perm_b32 v85, v179, v177, s45
    v_perm_b32 v86, v175, v173, s45
    v_perm_b32 v87, v183, v181, s45
    s_mov_b32 s46, 0
L_opoll:
    s_waitcnt vmcnt(0)
    v_bitop3_b32 v5, v53, v55, s31 bitop3:0x7e
    v_bitop3_b32 v6, v57, v59, s31 bitop3:0x7e
    v_or_b32 v5, v5, v6
    v_cmp_ne_u32 s[58:59], 0, v5
    v_bitop3_b32 v5, v61, v63, s31 bitop3:0x7e
    v_bitop3_b32 v6, v65, v67, s31 bitop3:0x7e
    v_or_b32 v5, v5, v6
    v_cmp_ne_u32 s[60:61], 0, v5
    s_or_b64 s[62:63], s[58:59], s[60:61]
    s_cbranch_scc0 L_ook
    s_add_u32 s46, s46, 1
    s_cmp_lt_u32 s46, 65536
    s_cbranch_scc0 L_ook
    s_mov_b64 exec, s[58:59]
    s_cbranch_execz L_o1
    buffer_load_dwordx4 v[52:55], v241, s[32:35], s54 offen offset:0 sc1 nt
    buffer_load_dwordx4 v[56:59], v241, s[32:35], s54 offen offset:1024 sc1 nt
L_o1:
    s_mov_b64 exec, s[60:61]
    s_cbranch_execz L_o2
    buffer_load_dwordx4 v[60:63], v241, s[32:35], s54 offen offset:2048 sc1 nt
    buffer_load_dwordx4 v[64:67], v241, s[32:35], s54 offen offset:3072 sc1 nt
L_o2:
    s_mov_b64 exec, -1
    s_branch L_opoll
L_ook:
    v_mov_b32 v53, v56
    v_mov_b32 v55, v58
    v_mov_b32 v61, v64
    v_mov_b32 v63, v66
    s_nop 0
    v_mfma_f32_16x16x32_bf16 v[112:115], v[52:55], v[72:75], 0
    v_mfma_f32_16x16x32_bf16 v[116:119], v[52:55], v[76:79], 0
    v_mfma_f32_16x16x32_bf16 v[120:123], v[52:55], v[80:83], 0
    v_mfma_f32_16x16x32_bf16 v[124:127], v[52:55], v[84:87], 0
    v_mfma_f32_16x16x32_bf16 v[128:131], v[60:63], v[72:75], 0
    v_mfma_f32_16x16x32_bf16 v[132:135], v[60:63], v[76:79], 0
    v_mfma_f32_16x16x32_bf16 v[136:139], v[60:63], v[80:83], 0
    v_mfma_f32_16x16x32_bf16 v[140:143], v[60:63], v[84:87], 0
    s_nop 0
    v_fmac_f32_dpp v144, v148, v112 row_newbcast:0 row_mask:0xf bank_mask:0xf
    v_fmac_f32_dpp v145, v148, v116 row_newbcast:0 row_mask:0xf bank_mask:0xf
    v_fmac_f32_dpp v146, v148, v120 row_newbcast:0 row_mask:0xf bank_mask:0xf
    v_fmac_f32_dpp v147, v148, v124 row_newbcast:0 row_mask:0xf bank_mask:0xf
    v_fmac_f32_dpp v144, v148, v113 row_newbcast:1 row_mask:0xf bank_mask:0xf
    v_fmac_f32_dpp v145, v148, v117 row_newbcast:1 row_mask:0xf bank_mask:0xf
    v_fmac_f32_dpp v146, v148, v121 row_newbcast:1 row_mask:0xf bank_mask:0xf
    v_fmac_f32_dpp v147, v148, v125 row_newbcast:1 row_mask:0xf bank_mask:0xf
    v_fmac_f32_dpp v144, v148, v114 row_newbcast:2 row_mask:0xf bank_mask:0xf
    v_fmac_f32_dpp v145, v148, v118 row_newbcast:2 row_mask:0xf bank_mask:0xf
    v_fmac_f32_dpp v146, v148, v122 row_newbcast:2 row_mask:0xf bank_mask:0xf
    v_fmac_f32_dpp v147, v148, v126 row_newbcast:2 row_mask:0xf bank_mask:0xf
    v_fmac_f32_dpp v144, v148, v115 row_newbcast:3 row_mask:0xf bank_mask:0xf
    v_fmac_f32_dpp v145, v148, v119 row_newbcast:3 row_mask:0xf bank_mask:0xf
    v_fmac_f32_dpp v146, v148, v123 row_newbcast:3 row_mask:0xf bank_mask:0xf
    v_fmac_f32_dpp v147, v148, v127 row_newbcast:3 row_mask:0xf bank_mask:0xf
    v_fmac_f32_dpp v144, v148, v128 row_newbcast:4 row_mask:0xf bank_mask:0xf
    v_fmac_f32_dpp v145, v148, v132 row_newbcast:4 row_mask:0xf bank_mask:0xf
    v_fmac_f32_dpp v146, v148, v136 row_newbcast:4 row_mask:0xf bank_mask:0xf
    v_fmac_f32_dpp v147, v148, v140 row_newbcast:4 row_mask:0xf bank_mask:0xf
    v_fmac_f32_dpp v144, v148, v129 row_newbcast:5 row_mask:0xf bank_mask:0xf
    v_fmac_f32_dpp v145, v148, v133 row_newbcast:5 row_mask:0xf bank_mask:0xf
    v_fmac_f32_dpp v146, v148, v137 row_newbcast:5 row_mask:0xf bank_mask:0xf
    v_fmac_f32_dpp v147, v148, v141 row_newbcast:5 row_mask:0xf bank_mask:0xf
    v_fmac_f32_dpp v144, v148, v130 row_newbcast:6 row_mask:0xf bank_mask:0xf
    v_fmac_f32_dpp v145, v148, v134 row_newbcast:6 row_mask:0xf bank_mask:0xf
    v_fmac_f32_dpp v146, v148, v138 row_newbcast:6 row_mask:0xf bank_mask:0xf
    v_fmac_f32_dpp v147, v148, v142 row_newbcast:6 row_mask:0xf bank_mask:0xf
    v_fmac_f32_dpp v144, v148, v131 row_newbcast:7 row_mask:0xf bank_mask:0xf
    v_fmac_f32_dpp v145, v148, v135 row_newbcast:7 row_mask:0xf bank_mask:0xf
    v_fmac_f32_dpp v146, v148, v139 row_newbcast:7 row_mask:0xf bank_mask:0xf
    v_fmac_f32_dpp v147, v148, v143 row_newbcast:7 row_mask:0xf bank_mask:0xf
    ds_write_b128 v223, v[144:147]
    s_waitcnt lgkmcnt(0)
    s_barrier
    s_cmp_ge_u32 s28, 2
    s_cbranch_scc1 L_final
    ds_read_b64 v[8:9], v217 offset:0
    ds_read_b64 v[10:11], v217 offset:1024
    ds_read_b64 v[12:13], v217 offset:2048
    ds_read_b64 v[14:15], v217 offset:3072
    v_mov_b32 v17, s31
    v_mov_b32 v19, s31
    s_waitcnt lgkmcnt(2)
    v_pk_add_f32 v[8:9], v[8:9], v[10:11]
    s_waitcnt lgkmcnt(0)
    v_pk_add_f32 v[12:13], v[12:13], v[14:15]
    v_add_f32 v16, v8, v12
    v_add_f32 v18, v9, v13
    buffer_store_dwordx4 v[16:19], v166, s[32:35], s55 offen sc1
    s_endpgm
L_final:
    s_cmp_eq_u32 s28, 2
    s_cbranch_scc0 L_svcend
    s_lshl_b32 s50, s99, 11
    s_add_u32 s50, s50, 1560576
    s_lshl_b32 s51, s99, 4
    v_lshlrev_b32 v20, 16, v250
    v_and_b32 v21, 0xffff0000, v250
    s_mov_b32 s46, 0
    s_sleep 10
L_hpoll:
    buffer_load_dwordx4 v[8:11], v241, s[32:35], s50 offen sc1
    buffer_load_dwordx4 v[12:15], v241, s[32:35], s50 offen offset:1024 sc1
    s_add_u32 s46, s46, 1
    s_waitcnt vmcnt(0)
    v_bitop3_b32 v9, v9, v11, s31 bitop3:0x7e
    v_bitop3_b32 v13, v13, v15, s31 bitop3:0x7e
    v_add_f32 v8, v8, v12
    v_add_f32 v10, v10, v14
    v_or_b32 v9, v9, v13
    v_cmp_ne_u32 vcc, 0, v9
    s_cbranch_vccz L_hok
    s_cmp_lt_u32 s46, 65536
    s_cbranch_scc1 L_hpoll
L_hok:
    v_add_f32_dpp v8, v8, v8 row_ror:4 row_mask:0xf bank_mask:0xf
    v_add_f32_dpp v10, v10, v10 row_ror:4 row_mask:0xf bank_mask:0xf
    s_nop 0
    v_add_f32_dpp v8, v8, v8 row_ror:8 row_mask:0xf bank_mask:0xf
    v_add_f32_dpp v10, v10, v10 row_ror:8 row_mask:0xf bank_mask:0xf
    s_nop 0
    v_mov_b32 v9, v8
    v_mov_b32 v11, v10
    s_nop 0
    v_permlane16_swap_b32 v8, v9
    v_permlane16_swap_b32 v10, v11
    s_nop 0
    v_add_f32 v8, v8, v9
    v_add_f32 v10, v10, v11
    v_mov_b32 v9, v8
    v_mov_b32 v11, v10
    s_nop 0
    v_permlane32_swap_b32 v8, v9
    v_permlane32_swap_b32 v10, v11
    s_nop 0
    v_add_f32 v8, v8, v9
    v_add_f32 v10, v10, v11
    v_add_f32 v8, v8, v20
    v_add_f32 v10, v10, v21
    s_mov_b64 exec, 15
    v_cvt_pk_bf16_f32 v8, v8, v10
    buffer_store_dword v8, v251, s[40:43], s51 offen
    s_cmp_eq_u32 s2, 0
    s_cbranch_scc0 L_svcend
    s_mov_b64 exec, 1
    s_add_u32 s51, s14, 1
    v_mov_b32 v9, s51
    buffer_store_dword v9, v167, s[32:35], 0 offen offset:0
L_svcend:
    s_endpgm
.p2align 6
L_att:
    s_mov_b32 s40, s8
    s_and_b32 s41, s9, 0xffff
    s_mov_b32 s42, 134217728
    s_mov_b32 s43, 0x20000
    v_lshlrev_b32 v20, 4, v0
    s_and_b32 s54, s52, 0x1ffff
    s_add_u32 s54, s54, s51
    s_add_u32 s52, s52, 16384
    s_waitcnt vmcnt(5)
    buffer_load_dwordx4 v[128:131], v20, s[40:43], s54 offen offset:0 nt
    s_waitcnt vmcnt(5)
    buffer_load_dwordx4 v[132:135], v20, s[40:43], s54 offen offset:1024 nt
    s_mov_b32 s44, 0x05040100
    s_mov_b32 s45, 0x07060302
    s_lshl_b32 s56, s50, 2
    s_add_u32 s56, s56, 132608
    v_mov_b32 v21, s56
    v_mov_b32 v22, 1
    s_waitcnt vmcnt(5)
    buffer_load_dwordx4 v[136:139], v20, s[40:43], s54 offen offset:2048 nt
    s_waitcnt vmcnt(5)
    buffer_load_dwordx4 v[140:143], v20, s[40:43], s54 offen offset:3072 nt
    s_and_b32 s54, s52, 0x1ffff
    s_add_u32 s54, s54, s51
    s_add_u32 s52, s52, 16384
    s_waitcnt vmcnt(5)
    buffer_load_dwordx4 v[144:147], v20, s[40:43], s54 offen offset:0 nt
    s_waitcnt vmcnt(5)
    buffer_load_dwordx4 v[148:151], v20, s[40:43], s54 offen offset:1024 nt
    s_waitcnt vmcnt(5)
    buffer_load_dwordx4 v[152:155], v20, s[40:43], s54 offen offset:2048 nt
    s_waitcnt vmcnt(7)
    ds_write_b32 v21, v22
    s_waitcnt vmcnt(5)
    buffer_load_dwordx4 v[156:159], v20, s[40:43], s54 offen offset:3072 nt
    s_and_b32 s54, s52, 0x1ffff
    s_add_u32 s54, s54, s51
    s_add_u32 s52, s52, 16384
    s_waitcnt vmcnt(5)
    buffer_load_dwordx4 v[160:163], v20, s[40:43], s54 offen offset:0 nt
    s_waitcnt vmcnt(5)
    buffer_load_dwordx4 v[164:167], v20, s[40:43], s54 offen offset:1024 nt
    s_waitcnt vmcnt(5)
    buffer_load_dwordx4 v[168:171], v20, s[40:43], s54 offen offset:2048 nt
    s_waitcnt vmcnt(5)
    buffer_load_dwordx4 v[172:175], v20, s[40:43], s54 offen offset:3072 nt
    s_and_b32 s54, s52, 0x1ffff
    s_add_u32 s54, s54, s51
    s_add_u32 s52, s52, 16384
    s_waitcnt vmcnt(5)
    buffer_load_dwordx4 v[176:179], v20, s[40:43], s54 offen offset:0 nt
    s_mov_b32 s32, s26
    s_and_b32 s33, s27, 0xffff
    s_mov_b32 s34, 2084864
    s_mov_b32 s35, 0x20000
    v_and_b32 v4, 3, v3
    v_mul_u32_u24 v4, 320, v4
    v_lshl_add_u32 v4, v2, 4, v4
    s_mul_i32 s56, s50, 1280
    s_add_u32 s56, s56, 132928
    v_add_u32 v4, s56, v4
    v_lshrrev_b32 v5, 2, v3
    v_mov_b32 v6, 132352
    v_cmp_eq_u32 vcc, 0, v5
    s_nop 1
    v_cndmask_b32 v16, v6, v4, vcc
    v_cmp_eq_u32 vcc, 1, v5
    s_nop 1
    v_cndmask_b32 v17, v6, v4, vcc
    v_cmp_eq_u32 vcc, 2, v5
    s_nop 1
    v_cndmask_b32 v18, v6, v4, vcc
    v_cmp_eq_u32 vcc, 3, v5
    s_nop 1
    v_cndmask_b32 v19, v6, v4, vcc
    v_mov_b32 v4, 132864
    s_lshl_b32 s56, s50, 4
    s_add_u32 s56, s56, 132864
    v_mov_b32 v5, s56
    v_lshlrev_b32 v60, 2, v3
    v_add_u32 v60, 132608, v60
    s_waitcnt vmcnt(5)
    buffer_load_dwordx4 v[180:183], v20, s[40:43], s54 offen offset:1024 nt
    s_lshl_b32 s56, s50, 11
    s_add_u32 s56, s56, 138048
    v_lshl_add_u32 v61, v0, 3, s56
    s_lshl_b32 s56, s50, 9
    s_add_u32 s56, s56, 138048
    v_lshl_add_u32 v62, v0, 4, s56
    s_lshl2_add_u32 s55, s29, s50
    s_lshl_b32 s55, s55, 14
    s_bfe_u32 s56, s30, 0x10002
    s_lshl_b32 s56, s56, 11
    s_add_u32 s55, s55, s56
    s_lshr_b32 s56, s30, 3
    s_lshl_b32 s56, s56, 6
    s_add_u32 s55, s55, s56
    s_and_b32 s56, s30, 3
    s_lshl_b32 s56, s56, 4
    s_add_u32 s55, s55, s56
    s_add_u32 s55, s55, 1036288
    v_bfe_u32 v63, v0, 3, 2
    v_lshlrev_b32 v63, 12, v63
    v_and_b32 v7, 1, v0
    v_lshl_add_u32 v63, v7, 10, v63
    v_bfe_u32 v7, v0, 1, 2
    v_lshl_add_u32 v63, v7, 8, v63
    s_waitcnt lgkmcnt(0)
    s_mul_i32 s31, s14, 0x9e3779b1
    s_add_u32 s31, s31, 0x7f4a7c18
    s_andn2_b32 s31, s31, 7
    s_waitcnt vmcnt(5)
    buffer_load_dwordx4 v[184:187], v20, s[40:43], s54 offen offset:2048 nt
    s_waitcnt vmcnt(5)
    buffer_load_dwordx4 v[188:191], v20, s[40:43], s54 offen offset:3072 nt
    s_and_b32 s54, s52, 0x1ffff
    s_add_u32 s54, s54, s51
    s_add_u32 s52, s52, 16384
    s_waitcnt vmcnt(5)
    buffer_load_dwordx4 v[192:195], v20, s[40:43], s54 offen offset:0 nt
    s_waitcnt vmcnt(5)
    buffer_load_dwordx4 v[196:199], v20, s[40:43], s54 offen offset:1024 nt
    s_waitcnt vmcnt(5)
    buffer_load_dwordx4 v[200:203], v20, s[40:43], s54 offen offset:2048 nt
    s_waitcnt vmcnt(5)
    buffer_load_dwordx4 v[204:207], v20, s[40:43], s54 offen offset:3072 nt
    s_mov_b32 s46, 0
L_spin_p:
    ds_read_b32 v7, v60
    s_waitcnt lgkmcnt(0)
    v_cmp_ne_u32 vcc, 0, v7
    s_and_b32 s57, vcc_lo, 0x1e00
    s_cmp_eq_u32 s57, 0x1e00
    s_cbranch_scc1 L_spin_p_done
    s_sleep 2
    s_add_u32 s46, s46, 1
    s_cmp_lt_u32 s46, 524288
    s_cbranch_scc1 L_spin_p
L_spin_p_done:
    v_readlane_b32 s15, v7, 4
    ds_read_b128 v[24:27], v4 offset:0
    ds_read_b128 v[28:31], v4 offset:16
    ds_read_b128 v[32:35], v4 offset:32
    ds_read_b128 v[36:39], v4 offset:48
    ds_read_b128 v[56:59], v5
    ds_read_b128 v[64:67], v16 offset:0
    ds_read_b128 v[68:71], v17 offset:0
    ds_read_b128 v[72:75], v18 offset:0
    ds_read_b128 v[76:79], v19 offset:0
    ds_read_b128 v[80:83], v16 offset:64
    ds_read_b128 v[84:87], v17 offset:64
    ds_read_b128 v[88:91], v18 offset:64
    ds_read_b128 v[92:95], v19 offset:64
    s_and_b32 s15, s15, 2
    s_and_b32 s54, s52, 0x1ffff
    s_add_u32 s54, s54, s51
    s_add_u32 s52, s52, 16384
    s_waitcnt vmcnt(5)
    buffer_load_dwordx4 v[208:211], v20, s[40:43], s54 offen offset:0 nt
    s_mov_b32 s57, 0x3fb8aa3b
    s_waitcnt lgkmcnt(0)
    ds_read_b128 v[96:99], v16 offset:128
    ds_read_b128 v[100:103], v17 offset:128
    ds_read_b128 v[104:107], v18 offset:128
    ds_read_b128 v[108:111], v19 offset:128
    ds_read_b128 v[112:115], v16 offset:192
    ds_read_b128 v[116:119], v17 offset:192
    ds_read_b128 v[120:123], v18 offset:192
    ds_read_b128 v[124:127], v19 offset:192
    v_max3_f32 v24, v24, v28, v32
    v_max3_f32 v25, v25, v29, v33
    v_max3_f32 v26, v26, v30, v34
    v_max3_f32 v27, v27, v31, v35
    v_max_f32 v24, v24, v36
    v_max_f32 v25, v25, v37
    v_max_f32 v26, v26, v38
    v_max_f32 v27, v27, v39
    v_sub_f32 v56, v56, v24
    v_sub_f32 v57, v57, v25
    v_sub_f32 v58, v58, v26
    v_sub_f32 v59, v59, v27
    v_mul_f32 v56, s57, v56
    v_mul_f32 v57, s57, v57
    v_mul_f32 v58, s57, v58
    v_mul_f32 v59, s57, v59
    v_exp_f32 v56, v56
    v_exp_f32 v57, v57
    v_exp_f32 v58, v58
    v_exp_f32 v59, v59
    s_waitcnt vmcnt(5)
    buffer_load_dwordx4 v[212:215], v20, s[40:43], s54 offen offset:1024 nt
    s_waitcnt vmcnt(14) lgkmcnt(0)
    v_perm_b32 v24, v132, v128, s44
    v_perm_b32 v25, v140, v136, s44
    v_perm_b32 v26, v148, v144, s44
    v_perm_b32 v27, v156, v152, s44
    v_perm_b32 v28, v132, v128, s45
    v_perm_b32 v29, v140, v136, s45
    v_perm_b32 v30, v148, v144, s45
    v_perm_b32 v31, v156, v152, s45
    v_mfma_f32_16x16x32_bf16 v[8:11], v[64:67], v[24:27], 0
    v_perm_b32 v32, v133, v129, s44
    v_perm_b32 v33, v141, v137, s44
    v_perm_b32 v34, v149, v145, s44
    v_perm_b32 v35, v157, v153, s44
    v_mfma_f32_16x16x32_bf16 v[12:15], v[64:67], v[28:31], 0
    v_perm_b32 v36, v133, v129, s45
    v_perm_b32 v37, v141, v137, s45
    v_perm_b32 v38, v149, v145, s45
    v_perm_b32 v39, v157, v153, s45
    v_mfma_f32_16x16x32_bf16 v[8:11], v[68:71], v[32:35], v[8:11]
    s_nop 1
    v_mfma_f32_16x16x32_bf16 v[12:15], v[68:71], v[36:39], v[12:15]
    s_waitcnt vmcnt(5)
    buffer_load_dwordx4 v[216:219], v20, s[40:43], s54 offen offset:2048 nt
    v_perm_b32 v40, v134, v130, s44
    v_perm_b32 v41, v142, v138, s44
    v_perm_b32 v42, v150, v146, s44
    v_perm_b32 v43, v158, v154, s44
    v_perm_b32 v44, v134, v130, s45
    v_perm_b32 v45, v142, v138, s45
    v_perm_b32 v46, v150, v146, s45
    v_perm_b32 v47, v158, v154, s45
    v_mfma_f32_16x16x32_bf16 v[8:11], v[72:75], v[40:43], v[8:11]
    v_perm_b32 v48, v135, v131, s44
    v_perm_b32 v49, v143, v139, s44
    v_perm_b32 v50, v151, v147, s44
    v_perm_b32 v51, v159, v155, s44
    v_mfma_f32_16x16x32_bf16 v[12:15], v[72:75], v[44:47], v[12:15]
    v_perm_b32 v52, v135, v131, s45
    v_perm_b32 v53, v143, v139, s45
    v_perm_b32 v54, v151, v147, s45
    v_perm_b32 v55, v159, v155, s45
    v_mfma_f32_16x16x32_bf16 v[8:11], v[76:79], v[48:51], v[8:11]
    s_nop 1
    v_mfma_f32_16x16x32_bf16 v[12:15], v[76:79], v[52:55], v[12:15]
    s_waitcnt vmcnt(5)
    buffer_load_dwordx4 v[220:223], v20, s[40:43], s54 offen offset:3072 nt
    s_waitcnt vmcnt(8) lgkmcnt(0)
    v_perm_b32 v24, v164, v160, s44
    v_perm_b32 v25, v172, v168, s44
    v_perm_b32 v26, v180, v176, s44
    v_perm_b32 v27, v188, v184, s44
    v_perm_b32 v28, v164, v160, s45
    v_perm_b32 v29, v172, v168, s45
    v_perm_b32 v30, v180, v176, s45
    v_perm_b32 v31, v188, v184, s45
    v_mfma_f32_16x16x32_bf16 v[8:11], v[80:83], v[24:27], v[8:11]
    v_perm_b32 v32, v165, v161, s44
    v_perm_b32 v33, v173, v169, s44
    v_perm_b32 v34, v181, v177, s44
    v_perm_b32 v35, v189, v185, s44
    v_mfma_f32_16x16x32_bf16 v[12:15], v[80:83], v[28:31], v[12:15]
    v_perm_b32 v36, v165, v161, s45
    v_perm_b32 v37, v173, v169, s45
    v_perm_b32 v38, v181, v177, s45
    v_perm_b32 v39, v189, v185, s45
    v_mfma_f32_16x16x32_bf16 v[8:11], v[84:87], v[32:35], v[8:11]
    s_nop 1
    v_mfma_f32_16x16x32_bf16 v[12:15], v[84:87], v[36:39], v[12:15]
    s_and_b32 s54, s52, 0x1ffff
    s_add_u32 s54, s54, s51
    s_add_u32 s52, s52, 16384
    s_waitcnt vmcnt(5)
    buffer_load_dwordx4 v[224:227], v20, s[40:43], s54 offen offset:0 nt
    v_perm_b32 v40, v166, v162, s44
    v_perm_b32 v41, v174, v170, s44
    v_perm_b32 v42, v182, v178, s44
    v_perm_b32 v43, v190, v186, s44
    v_perm_b32 v44, v166, v162, s45
    v_perm_b32 v45, v174, v170, s45
    v_perm_b32 v46, v182, v178, s45
    v_perm_b32 v47, v190, v186, s45
    v_mfma_f32_16x16x32_bf16 v[8:11], v[88:91], v[40:43], v[8:11]
    v_perm_b32 v48, v167, v163, s44
    v_perm_b32 v49, v175, v171, s44
    v_perm_b32 v50, v183, v179, s44
    v_perm_b32 v51, v191, v187, s44
    v_mfma_f32_16x16x32_bf16 v[12:15], v[88:91], v[44:47], v[12:15]
    v_perm_b32 v52, v167, v163, s45
    v_perm_b32 v53, v175, v171, s45
    v_perm_b32 v54, v183, v179, s45
    v_perm_b32 v55, v191, v187, s45
    v_mfma_f32_16x16x32_bf16 v[8:11], v[92:95], v[48:51], v[8:11]
    s_nop 1
    v_mfma_f32_16x16x32_bf16 v[12:15], v[92:95], v[52:55], v[12:15]
    s_waitcnt vmcnt(5)
    buffer_load_dwordx4 v[228:231], v20, s[40:43], s54 offen offset:1024 nt
    s_waitcnt vmcnt(5)
    buffer_load_dwordx4 v[232:235], v20, s[40:43], s54 offen offset:2048 nt
    s_waitcnt vmcnt(5)
    buffer_load_dwordx4 v[236:239], v20, s[40:43], s54 offen offset:3072 nt
    s_and_b32 s54, s52, 0x1ffff
    s_add_u32 s54, s54, s51
    s_add_u32 s52, s52, 16384
    buffer_load_dwordx4 v[240:243], v20, s[40:43], s54 offen offset:0 nt
    buffer_load_dwordx4 v[244:247], v20, s[40:43], s54 offen offset:1024 nt
    buffer_load_dwordx4 v[248:251], v20, s[40:43], s54 offen offset:2048 nt
    buffer_load_dwordx4 v[252:255], v20, s[40:43], s54 offen offset:3072 nt
    s_barrier
    s_waitcnt vmcnt(8) lgkmcnt(0)
    v_perm_b32 v24, v196, v192, s44
    v_perm_b32 v25, v204, v200, s44
    v_perm_b32 v26, v212, v208, s44
    v_perm_b32 v27, v220, v216, s44
    v_perm_b32 v28, v196, v192, s45
    v_perm_b32 v29, v204, v200, s45
    v_perm_b32 v30, v212, v208, s45
    v_perm_b32 v31, v220, v216, s45
    v_mfma_f32_16x16x32_bf16 v[8:11], v[96:99], v[24:27], v[8:11]
    v_perm_b32 v32, v197, v193, s44
    v_perm_b32 v33, v205, v201, s44
    v_perm_b32 v34, v213, v209, s44
    v_perm_b32 v35, v221, v217, s44
    v_mfma_f32_16x16x32_bf16 v[12:15], v[96:99], v[28:31], v[12:15]
    v_perm_b32 v36, v197, v193, s45
    v_perm_b32 v37, v205, v201, s45
    v_perm_b32 v38, v213, v209, s45
    v_perm_b32 v39, v221, v217, s45
    v_mfma_f32_16x16x32_bf16 v[8:11], v[100:103], v[32:35], v[8:11]
    s_nop 1
    v_mfma_f32_16x16x32_bf16 v[12:15], v[100:103], v[36:39], v[12:15]
    v_perm_b32 v40, v198, v194, s44
    v_perm_b32 v41, v206, v202, s44
    v_perm_b32 v42, v214, v210, s44
    v_perm_b32 v43, v222, v218, s44
    v_perm_b32 v44, v198, v194, s45
    v_perm_b32 v45, v206, v202, s45
    v_perm_b32 v46, v214, v210, s45
    v_perm_b32 v47, v222, v218, s45
    v_mfma_f32_16x16x32_bf16 v[8:11], v[104:107], v[40:43], v[8:11]
    v_perm_b32 v48, v199, v195, s44
    v_perm_b32 v49, v207, v203, s44
    v_perm_b32 v50, v215, v211, s44
    v_perm_b32 v51, v223, v219, s44
    v_mfma_f32_16x16x32_bf16 v[12:15], v[104:107], v[44:47], v[12:15]
    v_perm_b32 v52, v199, v195, s45
    v_perm_b32 v53, v207, v203, s45
    v_perm_b32 v54, v215, v211, s45
    v_perm_b32 v55, v223, v219, s45
    v_mfma_f32_16x16x32_bf16 v[8:11], v[108:111], v[48:51], v[8:11]
    s_nop 1
    v_mfma_f32_16x16x32_bf16 v[12:15], v[108:111], v[52:55], v[12:15]
    s_waitcnt vmcnt(6)
    v_perm_b32 v24, v228, v224, s44
    v_perm_b32 v28, v228, v224, s45
    v_perm_b32 v32, v229, v225, s44
    v_perm_b32 v36, v229, v225, s45
    v_perm_b32 v40, v230, v226, s44
    v_perm_b32 v44, v230, v226, s45
    v_perm_b32 v48, v231, v227, s44
    v_perm_b32 v52, v231, v227, s45
    s_waitcnt vmcnt(4)
    v_perm_b32 v25, v236, v232, s44
    v_perm_b32 v29, v236, v232, s45
    v_perm_b32 v33, v237, v233, s44
    v_perm_b32 v37, v237, v233, s45
    v_perm_b32 v41, v238, v234, s44
    v_perm_b32 v45, v238, v234, s45
    v_perm_b32 v49, v239, v235, s44
    v_perm_b32 v53, v239, v235, s45
    s_waitcnt vmcnt(2)
    v_perm_b32 v26, v244, v240, s44
    v_perm_b32 v30, v244, v240, s45
    v_perm_b32 v34, v245, v241, s44
    v_perm_b32 v38, v245, v241, s45
    v_perm_b32 v42, v246, v242, s44
    v_perm_b32 v46, v246, v242, s45
    v_perm_b32 v50, v247, v243, s44
    v_perm_b32 v54, v247, v243, s45
    s_waitcnt vmcnt(0)
    v_perm_b32 v27, v252, v248, s44
    v_perm_b32 v31, v252, v248, s45
    v_perm_b32 v35, v253, v249, s44
    v_mfma_f32_16x16x32_bf16 v[8:11], v[112:115], v[24:27], v[8:11]
    v_perm_b32 v39, v253, v249, s45
    v_mfma_f32_16x16x32_bf16 v[12:15], v[112:115], v[28:31], v[12:15]
    v_perm_b32 v43, v254, v250, s44
    v_mfma_f32_16x16x32_bf16 v[8:11], v[116:119], v[32:35], v[8:11]
    v_perm_b32 v47, v254, v250, s45
    v_mfma_f32_16x16x32_bf16 v[12:15], v[116:119], v[36:39], v[12:15]
    v_perm_b32 v51, v255, v251, s44
    v_mfma_f32_16x16x32_bf16 v[8:11], v[120:123], v[40:43], v[8:11]
    v_perm_b32 v55, v255, v251, s45
    v_mfma_f32_16x16x32_bf16 v[12:15], v[120:123], v[44:47], v[12:15]
    v_mfma_f32_16x16x32_bf16 v[8:11], v[124:127], v[48:51], v[8:11]
    v_mfma_f32_16x16x32_bf16 v[12:15], v[124:127], v[52:55], v[12:15]
    s_nop 6
    v_mul_f32 v24, v8, v56
    v_mul_f32 v26, v9, v57
    v_mul_f32 v28, v10, v58
    v_mul_f32 v30, v11, v59
    v_mul_f32 v25, v12, v56
    v_mul_f32 v27, v13, v57
    v_mul_f32 v29, v14, v58
    v_mul_f32 v31, v15, v59
    ds_write_b64 v61, v[24:25] offset:0
    ds_write_b64 v61, v[26:27] offset:512
    ds_write_b64 v61, v[28:29] offset:1024
    ds_write_b64 v61, v[30:31] offset:1536
    s_waitcnt lgkmcnt(0)
    s_barrier
    s_mov_b32 exec_hi, 0
    ds_read_b128 v[32:35], v62 offset:0
    ds_read_b128 v[36:39], v62 offset:2048
    ds_read_b128 v[40:43], v62 offset:4096
    ds_read_b128 v[44:47], v62 offset:6144
    v_mov_b32 v25, s31
    v_mov_b32 v27, s31
    s_waitcnt lgkmcnt(2)
    v_pk_add_f32 v[32:33], v[32:33], v[36:37]
    v_pk_add_f32 v[34:35], v[34:35], v[38:39]
    s_waitcnt lgkmcnt(0)
    v_pk_add_f32 v[40:41], v[40:41], v[44:45]
    v_pk_add_f32 v[42:43], v[42:43], v[46:47]
    v_pk_add_f32 v[32:33], v[32:33], v[40:41]
    v_pk_add_f32 v[34:35], v[34:35], v[42:43]
    v_cvt_pk_bf16_f32 v24, v32, v33
    v_cvt_pk_bf16_f32 v26, v34, v35
    s_cmp_eq_u32 s15, 0
    s_cbranch_scc0 L_sm_o
    buffer_store_dwordx4 v[24:27], v63, s[32:35], s55 offen
    s_branch L_sm_o_done
L_sm_o:
    buffer_store_dwordx4 v[24:27], v63, s[32:35], s55 offen sc1
L_sm_o_done:
L_end:
    s_endpgm
L_codeend:
.section .rodata,"a"
.p2align 6
.amdhsa_kernel parallel_sum__sliding_block_cached__swiglu_ffn__decode_kernel
  .amdhsa_next_free_vgpr 256
  .amdhsa_next_free_sgpr 100
  .amdhsa_accum_offset 256
  .amdhsa_group_segment_fixed_size 0
  .amdhsa_kernarg_size 96
  .amdhsa_user_sgpr_count 2
  .amdhsa_user_sgpr_kernarg_segment_ptr 1
  .amdhsa_system_sgpr_workgroup_id_x 1
  .amdhsa_float_denorm_mode_32 3
  .amdhsa_float_denorm_mode_16_64 3
.end_amdhsa_kernel
```
